```python
import torch

def _softmax(x, axis=-1):
    return torch.softmax(x, dim=axis)
def _gelu(x):
    return torch.nn.functional.gelu(x, approximate="tanh")
def _silu(x):
    return torch.nn.functional.silu(x)
def _sigmoid(x):
    return torch.sigmoid(x)
def _layernorm(x, axis=-1, eps=1e-5):
    m = x.mean(dim=axis, keepdim=True)
    v = x.var(dim=axis, keepdim=True, unbiased=False)
    return (x - m) / torch.sqrt(v + eps)
def _scatter_add(tgt, idx, src, axis=0):
    return tgt.clone().index_add_(axis, idx, src)
def _segment_sum(src, seg, n):
    out = torch.zeros((n,) + src.shape[1:], dtype=src.dtype)
    return out.index_add_(0, seg, src)
def _pad(x, pw):
    flat = tuple(v for pair in reversed(pw) for v in pair)
    return torch.nn.functional.pad(x, flat)

kernel_name = 'standalone__glu_gated_swiglu__sampling'

def setup_inputs():

    _w = (lambda a: (lambda t: t.to(torch.bfloat16) if t.is_floating_point() else t)(torch.as_tensor(a)))
    B, S, D, F = 16, 4, 1024, 3584
    return {
        "x": _w((lambda *s: torch.randn(*s, dtype=torch.bfloat16) * 0.05)(B, S, D)),
        "w1": _w((lambda *s: torch.randn(*s, dtype=torch.bfloat16) * 0.05)(D, F) * (2.0 / D) ** 0.5),
        "w3": _w((lambda *s: torch.randn(*s, dtype=torch.bfloat16) * 0.05)(D, F) * (2.0 / D) ** 0.5),
        "w2": _w((lambda *s: torch.randn(*s, dtype=torch.bfloat16) * 0.05)(F, D) * (2.0 / F) ** 0.5),
    }

def reference(x, w1, w3, w2):
    gate = torch.einsum("bsd,df->bsf", x, w1)
    up = torch.einsum("bsd,df->bsf", x, w3)
    h = _silu(gate) * up
    out = torch.einsum("bsf,fd->bsd", h, w2)
    return out
```

```asm
; @launch grid=(256,1,1) block=(512,1,1) lds=163840
.amdgcn_target "amdgcn-amd-amdhsa--gfx950"
.text
.globl standalone__glu_gated_swiglu__sampling_kernel
.p2align 8
.type standalone__glu_gated_swiglu__sampling_kernel,@function
standalone__glu_gated_swiglu__sampling_kernel:
s_load_dwordx8 s[4:11], s[0:1], 0
s_load_dwordx4 s[12:15], s[0:1], 32
s_load_dwordx2 s[16:17], s[0:1], 48
s_cmp_ge_u32 s2, 256
s_cbranch_scc1 Lend
v_lshrrev_b32 v1, 6, v0
v_and_b32 v0, 63, v0
s_and_b32 s44, s2, 7
v_readfirstlane_b32 s3, v1
s_lshr_b32 s45, s2, 3
s_lshl_b32 s46, s44, 20
s_and_b32 s47, s3, 3
s_cmp_lt_u32 s3, 4
s_cbranch_scc1 LP1
s_lshr_b32 s59, s45, 2
s_and_b32 s48, s45, 3
s_and_b32 s49, s45, 1
v_lshrrev_b32 v1, 3, v0
v_and_b32 v3, 7, v0
v_lshrrev_b32 v4, 2, v0
v_and_b32 v4, 4, v4
v_xor_b32 v6, v3, v4
v_mul_u32_u24 v14, 7168, v1
v_lshl_add_u32 v14, v6, 4, v14
s_and_b32 s50, s3, 1
s_lshl_b32 s50, s50, 2
v_lshrrev_b32 v4, 4, v0
v_add_u32 v4, s50, v4
v_xor_b32 v4, v3, v4
v_lshlrev_b32 v1, 11, v1
v_lshl_add_u32 v15, v4, 4, v1
v_lshl_add_u32 v2, v6, 4, v1
v_xor_b32 v3, 32, v2
s_lshl_b32 s50, s49, 9
s_lshl_b32 s51, s47, 3
s_add_u32 s50, s50, s51
s_mul_i32 s52, s50, 7168
s_mul_i32 s50, s44, 896
s_lshl_b32 s51, s59, 7
s_add_u32 s52, s52, s50
s_add_u32 s52, s52, s51
s_lshl_b32 s53, s47, 14
s_lshl_b32 s50, s49, 10
s_add_u32 s53, s53, s50
s_lshl_b32 s54, s47, 10
s_mov_b32 s26, 7340032
s_mov_b32 s27, 0x20000
s_mov_b32 s22, 131072
s_mov_b32 s23, 0x20000
s_cmp_ge_u32 s48, 2
s_waitcnt lgkmcnt(0)
s_cselect_b32 s24, s8, s6
s_cselect_b32 s25, s9, s7
s_and_b32 s25, s25, 0xffff
s_mov_b32 s20, s4
s_and_b32 s21, s5, 0xffff
s_cmp_ge_u32 s45, 28
s_cbranch_scc1 Lsk0
s_add_u32 m0, s54, 0
s_add_u32 s55, s52, 0
buffer_load_dwordx4 v14, s[24:27], s55 offen nt lds
s_add_u32 m0, s54, 4096
s_add_u32 s55, s52, 229376
buffer_load_dwordx4 v14, s[24:27], s55 offen nt lds
s_add_u32 m0, s54, 16384
s_add_u32 s55, s52, 458752
buffer_load_dwordx4 v14, s[24:27], s55 offen nt lds
s_add_u32 m0, s54, 20480
s_add_u32 s55, s52, 688128
buffer_load_dwordx4 v14, s[24:27], s55 offen nt lds
s_add_u32 m0, s54, 32768
s_add_u32 s55, s52, 917504
buffer_load_dwordx4 v14, s[24:27], s55 offen nt lds
s_add_u32 m0, s54, 36864
s_add_u32 s55, s52, 1146880
buffer_load_dwordx4 v14, s[24:27], s55 offen nt lds
s_add_u32 m0, s54, 49152
s_add_u32 s55, s52, 1376256
buffer_load_dwordx4 v14, s[24:27], s55 offen nt lds
s_add_u32 m0, s54, 53248
s_add_u32 s55, s52, 1605632
buffer_load_dwordx4 v14, s[24:27], s55 offen nt lds
s_add_u32 m0, s54, 65536
s_add_u32 s55, s52, 1835008
buffer_load_dwordx4 v14, s[24:27], s55 offen nt lds
s_add_u32 m0, s54, 69632
s_add_u32 s55, s52, 2064384
buffer_load_dwordx4 v14, s[24:27], s55 offen nt lds
s_add_u32 m0, s54, 81920
s_add_u32 s55, s52, 2293760
buffer_load_dwordx4 v14, s[24:27], s55 offen nt lds
s_add_u32 m0, s54, 86016
s_add_u32 s55, s52, 2523136
buffer_load_dwordx4 v14, s[24:27], s55 offen nt lds
s_add_u32 m0, s54, 98304
s_add_u32 s55, s52, 2752512
buffer_load_dwordx4 v14, s[24:27], s55 offen nt lds
s_add_u32 m0, s54, 102400
s_add_u32 s55, s52, 2981888
buffer_load_dwordx4 v14, s[24:27], s55 offen nt lds
s_add_u32 m0, s54, 114688
s_add_u32 s55, s52, 3211264
buffer_load_dwordx4 v14, s[24:27], s55 offen nt lds
s_add_u32 m0, s54, 118784
s_add_u32 s55, s52, 3440640
buffer_load_dwordx4 v14, s[24:27], s55 offen nt lds
Lsk0:
s_add_u32 s18, s16, 12582912
s_addc_u32 s19, s17, 0
s_load_dword s76, s[18:19], 0
s_mov_b32 s32, s16
s_and_b32 s33, s17, 0xffff
s_mov_b32 s34, 268435456
s_mov_b32 s35, 0x20000

s_mov_b32 s28, s10
s_and_b32 s29, s11, 0xffff
s_mov_b32 s30, 7340032
s_mov_b32 s31, 0x20000

s_mov_b32 s36, s12
s_and_b32 s37, s13, 0xffff
s_mov_b32 s38, 131072
s_mov_b32 s39, 0x20000

s_and_b32 s48, s45, 15
s_lshr_b32 s49, s45, 4
s_and_b32 s56, s47, 1
s_lshr_b32 s57, s47, 1
v_lshlrev_b32 v12, 4, v0
v_lshlrev_b32 v13, 2, v0
s_mul_i32 s43, s44, 448
s_lshl_b32 s50, s47, 3
s_add_u32 s43, s43, s50
s_lshl_b32 s43, s43, 11
s_lshl_b32 s50, s48, 7
s_add_u32 s43, s43, s50
s_mul_i32 s50, s49, 393216
s_add_u32 s40, s43, s50
s_lshl_b32 s50, s49, 19
s_sub_u32 s43, s43, s50
s_lshl_b32 s41, s47, 13
s_add_u32 s41, s41, 131072
s_mul_i32 s42, s47, 6144
v_bfe_u32 v1, v0, 4, 1
v_bfe_u32 v16, v0, 2, 2
v_lshl_add_u32 v16, v1, 3, v16
v_lshlrev_b32 v16, 7, v16
v_bfe_u32 v17, v0, 1, 1
v_lshl_add_u32 v17, v1, 1, v17
v_bfe_u32 v1, v0, 3, 1
v_xor_b32 v1, s57, v1
v_lshl_add_u32 v17, v1, 2, v17
v_lshl_add_u32 v16, v17, 4, v16
v_and_b32 v1, 1, v0
v_lshl_add_u32 v16, v1, 3, v16
v_lshrrev_b32 v1, 5, v0
s_lshl_b32 s50, s57, 1
v_add_u32 v1, s50, v1
v_lshlrev_b32 v17, 13, v1
v_add_u32 v17, 131072, v17
v_mul_u32_u24 v18, 6144, v1
v_xor_b32 v1, 0, v16
v_add_u32 v4, v1, v17
v_add_u32 v8, v1, v18
v_xor_b32 v1, 32, v16
v_add_u32 v5, v1, v17
v_add_u32 v9, v1, v18
v_xor_b32 v1, 64, v16
v_add_u32 v6, v1, v17
v_add_u32 v10, v1, v18
v_xor_b32 v1, 96, v16
v_add_u32 v7, v1, v17
v_add_u32 v11, v1, v18
s_lshl_b32 s50, s57, 2
s_add_u32 s50, s50, s56
s_mul_i32 s51, s49, 26
s_add_u32 s51, s51, s50
s_mul_i32 s59, s49, 30
s_sub_u32 s59, s50, s59
s_add_u32 s59, s59, 32
s_lshl_b32 s68, s51, 10
s_lshl_b32 s72, s59, 10
s_lshl_b32 s60, s51, 8
s_lshl_b32 s62, s59, 8
s_add_u32 s50, s46, 458752
s_add_u32 s68, s68, s50
s_add_u32 s72, s72, s50
s_add_u32 s50, s46, 516096
s_add_u32 s60, s60, s50
s_add_u32 s62, s62, s50
s_add_u32 s69, s68, 8192
s_add_u32 s70, s68, 16384
s_add_u32 s71, s68, 24576
s_add_u32 s73, s72, 8192
s_add_u32 s74, s72, 16384
s_add_u32 s61, s60, 4096
s_add_u32 s63, s62, 4096
s_lshl_b32 s58, s44, 5
s_add_u32 s58, s58, s45
s_lshl_b32 s58, s58, 13
s_lshl_b32 s50, s56, 12
s_add_u32 s58, s58, s50
s_lshl_b32 s50, s57, 9
s_add_u32 s58, s58, s50
s_add_u32 s58, s58, 8388608
v_lshrrev_b32 v1, 4, v0
v_and_b32 v29, 15, v0
v_lshlrev_b32 v16, 10, v1
v_lshl_add_u32 v16, v29, 4, v16
v_lshlrev_b32 v27, 18, v1
v_lshl_add_u32 v27, v29, 4, v27
v_lshlrev_b32 v28, 11, v1
v_lshl_add_u32 v28, v29, 1, v28
s_lshl_b32 s50, s47, 11
v_add_u32 v17, s50, v12
v_xor_b32 v18, 4096, v17
s_lshl_b32 s64, s45, 13
s_lshl_b32 s50, s44, 10
s_add_u32 s64, s64, s50
s_lshl_b32 s50, s47, 8
s_add_u32 s64, s64, s50
s_add_u32 s64, s64, 8388608
s_add_u32 s67, s64, 1048576
s_lshl_b32 s65, s49, 3
s_add_u32 s65, s65, s44
s_lshl_b32 s65, s65, 13
s_lshl_b32 s50, s48, 7
s_add_u32 s65, s65, s50
s_lshl_b32 s50, s47, 5
s_add_u32 s65, s65, s50
v_mov_b32 v176, 0
v_mov_b32 v177, 0
v_mov_b32 v178, 0
v_mov_b32 v179, 0
v_mov_b32 v180, 0
v_mov_b32 v181, 0
v_mov_b32 v182, 0
v_mov_b32 v183, 0
v_mov_b32 v184, 0
v_mov_b32 v185, 0
v_mov_b32 v186, 0
v_mov_b32 v187, 0
v_mov_b32 v188, 0
v_mov_b32 v189, 0
v_mov_b32 v190, 0
v_mov_b32 v191, 0
s_cmp_ge_u32 s45, 28
s_cbranch_scc1 Lnp
s_add_u32 m0, s54, 8192
s_add_u32 s55, s53, 0
buffer_load_dwordx4 v15, s[20:23], s55 offen lds
s_add_u32 m0, s54, 12288
s_add_u32 s55, s53, 65536
buffer_load_dwordx4 v15, s[20:23], s55 offen lds
s_add_u32 m0, s54, 24576
s_add_u32 s55, s53, 128
buffer_load_dwordx4 v15, s[20:23], s55 offen lds
s_add_u32 m0, s54, 28672
s_add_u32 s55, s53, 65664
buffer_load_dwordx4 v15, s[20:23], s55 offen lds
s_add_u32 m0, s54, 40960
s_add_u32 s55, s53, 256
buffer_load_dwordx4 v15, s[20:23], s55 offen lds
s_add_u32 m0, s54, 45056
s_add_u32 s55, s53, 65792
buffer_load_dwordx4 v15, s[20:23], s55 offen lds
s_add_u32 m0, s54, 57344
s_add_u32 s55, s53, 384
buffer_load_dwordx4 v15, s[20:23], s55 offen lds
s_add_u32 m0, s54, 61440
s_add_u32 s55, s53, 65920
buffer_load_dwordx4 v15, s[20:23], s55 offen lds
s_add_u32 m0, s54, 73728
s_add_u32 s55, s53, 512
buffer_load_dwordx4 v15, s[20:23], s55 offen lds
s_add_u32 m0, s54, 77824
s_add_u32 s55, s53, 66048
buffer_load_dwordx4 v15, s[20:23], s55 offen lds
s_add_u32 m0, s54, 90112
s_add_u32 s55, s53, 640
buffer_load_dwordx4 v15, s[20:23], s55 offen lds
s_add_u32 m0, s54, 94208
s_add_u32 s55, s53, 66176
buffer_load_dwordx4 v15, s[20:23], s55 offen lds
s_waitcnt vmcnt(10)
s_barrier
s_add_u32 m0, s54, 106496
s_add_u32 s55, s53, 768
buffer_load_dwordx4 v15, s[20:23], s55 offen lds
s_add_u32 m0, s54, 110592
s_add_u32 s55, s53, 66304
buffer_load_dwordx4 v15, s[20:23], s55 offen lds
s_waitcnt vmcnt(10)
s_barrier
s_add_u32 m0, s54, 122880
s_add_u32 s55, s53, 896
buffer_load_dwordx4 v15, s[20:23], s55 offen lds
s_add_u32 m0, s54, 126976
s_add_u32 s55, s53, 66432
buffer_load_dwordx4 v15, s[20:23], s55 offen lds
s_waitcnt vmcnt(10)
s_barrier
s_add_u32 m0, s41, 0
s_add_u32 s50, s40, 0
buffer_load_dwordx4 v2, s[28:31], s50 offen lds
s_add_u32 m0, s41, 1024
s_add_u32 s50, s40, 65536
buffer_load_dwordx4 v3, s[28:31], s50 offen lds
s_add_u32 m0, s41, 2048
s_add_u32 s50, s40, 131072
buffer_load_dwordx4 v2, s[28:31], s50 offen lds
s_add_u32 m0, s41, 3072
s_add_u32 s50, s40, 196608
buffer_load_dwordx4 v3, s[28:31], s50 offen lds
s_add_u32 m0, s41, 4096
s_add_u32 s50, s40, 262144
buffer_load_dwordx4 v2, s[28:31], s50 offen lds
s_add_u32 m0, s41, 5120
s_add_u32 s50, s40, 327680
buffer_load_dwordx4 v3, s[28:31], s50 offen lds
s_add_u32 m0, s41, 6144
s_add_u32 s50, s40, 393216
buffer_load_dwordx4 v2, s[28:31], s50 offen lds
s_add_u32 m0, s41, 7168
s_add_u32 s50, s40, 458752
buffer_load_dwordx4 v3, s[28:31], s50 offen lds
s_waitcnt vmcnt(16)
s_barrier
s_waitcnt vmcnt(14)
s_barrier
s_waitcnt vmcnt(12)
s_barrier
s_waitcnt vmcnt(10)
s_barrier
s_waitcnt vmcnt(8) lgkmcnt(0)
s_barrier
Ljoin:
s_waitcnt lgkmcnt(0)
s_add_u32 s76, s76, 1
s_and_b32 s77, s76, 0xff
v_mov_b32 v60, s77
s_mov_b32 s75, 0xffffff00
s_mov_b32 s66, 100000
s_waitcnt vmcnt(0)
s_barrier
s_add_u32 m0, s42, 0
s_add_u32 s50, s43, 524288
buffer_load_dwordx4 v2, s[28:31], s50 offen lds
s_add_u32 m0, s42, 1024
s_add_u32 s50, s43, 589824
buffer_load_dwordx4 v3, s[28:31], s50 offen lds
s_add_u32 m0, s42, 2048
s_add_u32 s50, s43, 655360
buffer_load_dwordx4 v2, s[28:31], s50 offen lds
s_add_u32 m0, s42, 3072
s_add_u32 s50, s43, 720896
buffer_load_dwordx4 v3, s[28:31], s50 offen lds
s_add_u32 m0, s42, 4096
s_add_u32 s50, s43, 786432
buffer_load_dwordx4 v2, s[28:31], s50 offen lds
s_add_u32 m0, s42, 5120
s_add_u32 s50, s43, 851968
buffer_load_dwordx4 v3, s[28:31], s50 offen lds
ds_read_b64_tr_b16 v[64:65], v4 offset:0
ds_read_b64_tr_b16 v[66:67], v4 offset:512
ds_read_b64_tr_b16 v[68:69], v5 offset:0
ds_read_b64_tr_b16 v[70:71], v5 offset:512
ds_read_b64_tr_b16 v[72:73], v6 offset:0
ds_read_b64_tr_b16 v[74:75], v6 offset:512
ds_read_b64_tr_b16 v[76:77], v7 offset:0
ds_read_b64_tr_b16 v[78:79], v7 offset:512
s_waitcnt lgkmcnt(5)
ds_read_b64_tr_b16 v[80:81], v4 offset:2048
ds_read_b64_tr_b16 v[82:83], v4 offset:2560
ds_read_b64_tr_b16 v[84:85], v5 offset:2048
ds_read_b64_tr_b16 v[86:87], v5 offset:2560
ds_read_b64_tr_b16 v[88:89], v6 offset:2048
ds_read_b64_tr_b16 v[90:91], v6 offset:2560
ds_read_b64_tr_b16 v[92:93], v7 offset:2048
ds_read_b64_tr_b16 v[94:95], v7 offset:2560
s_waitcnt lgkmcnt(5)
ds_read_b64_tr_b16 v[96:97], v4 offset:4096
ds_read_b64_tr_b16 v[98:99], v4 offset:4608
ds_read_b64_tr_b16 v[100:101], v5 offset:4096
ds_read_b64_tr_b16 v[102:103], v5 offset:4608
ds_read_b64_tr_b16 v[104:105], v6 offset:4096
ds_read_b64_tr_b16 v[106:107], v6 offset:4608
ds_read_b64_tr_b16 v[108:109], v7 offset:4096
ds_read_b64_tr_b16 v[110:111], v7 offset:4608
s_waitcnt lgkmcnt(5)
ds_read_b64_tr_b16 v[112:113], v4 offset:6144
ds_read_b64_tr_b16 v[114:115], v4 offset:6656
ds_read_b64_tr_b16 v[116:117], v5 offset:6144
ds_read_b64_tr_b16 v[118:119], v5 offset:6656
ds_read_b64_tr_b16 v[120:121], v6 offset:6144
ds_read_b64_tr_b16 v[122:123], v6 offset:6656
ds_read_b64_tr_b16 v[124:125], v7 offset:6144
ds_read_b64_tr_b16 v[126:127], v7 offset:6656
s_waitcnt lgkmcnt(5)
s_waitcnt vmcnt(0)
s_barrier
buffer_load_dwordx4 v[32:35], v12, s[32:35], s68 offen sc1
buffer_load_dword v20, v13, s[32:35], s60 offen offset:0 sc1
buffer_load_dwordx4 v[36:39], v12, s[32:35], s69 offen sc1
buffer_load_dword v21, v13, s[32:35], s60 offen offset:2048 sc1
buffer_load_dwordx4 v[40:43], v12, s[32:35], s70 offen sc1
buffer_load_dword v22, v13, s[32:35], s61 offen offset:0 sc1
buffer_load_dwordx4 v[44:47], v12, s[32:35], s71 offen sc1
buffer_load_dword v23, v13, s[32:35], s61 offen offset:2048 sc1
buffer_load_dwordx4 v[48:51], v12, s[32:35], s72 offen sc1
buffer_load_dword v24, v13, s[32:35], s62 offen offset:0 sc1
buffer_load_dwordx4 v[52:55], v12, s[32:35], s73 offen sc1
buffer_load_dword v25, v13, s[32:35], s62 offen offset:2048 sc1
buffer_load_dwordx4 v[56:59], v12, s[32:35], s74 offen sc1
buffer_load_dword v26, v13, s[32:35], s63 offen offset:0 sc1
ds_read_b64_tr_b16 v[128:129], v8 offset:0
ds_read_b64_tr_b16 v[130:131], v8 offset:512
ds_read_b64_tr_b16 v[132:133], v9 offset:0
ds_read_b64_tr_b16 v[134:135], v9 offset:512
ds_read_b64_tr_b16 v[136:137], v10 offset:0
ds_read_b64_tr_b16 v[138:139], v10 offset:512
ds_read_b64_tr_b16 v[140:141], v11 offset:0
ds_read_b64_tr_b16 v[142:143], v11 offset:512
s_waitcnt lgkmcnt(5)
ds_read_b64_tr_b16 v[144:145], v8 offset:2048
ds_read_b64_tr_b16 v[146:147], v8 offset:2560
ds_read_b64_tr_b16 v[148:149], v9 offset:2048
ds_read_b64_tr_b16 v[150:151], v9 offset:2560
ds_read_b64_tr_b16 v[152:153], v10 offset:2048
ds_read_b64_tr_b16 v[154:155], v10 offset:2560
ds_read_b64_tr_b16 v[156:157], v11 offset:2048
ds_read_b64_tr_b16 v[158:159], v11 offset:2560
s_waitcnt lgkmcnt(5)
ds_read_b64_tr_b16 v[160:161], v8 offset:4096
ds_read_b64_tr_b16 v[162:163], v8 offset:4608
ds_read_b64_tr_b16 v[164:165], v9 offset:4096
ds_read_b64_tr_b16 v[166:167], v9 offset:4608
ds_read_b64_tr_b16 v[168:169], v10 offset:4096
ds_read_b64_tr_b16 v[170:171], v10 offset:4608
ds_read_b64_tr_b16 v[172:173], v11 offset:4096
ds_read_b64_tr_b16 v[174:175], v11 offset:4608
s_waitcnt lgkmcnt(0)
LB0:
s_waitcnt vmcnt(12)
v_add3_u32 v1, v32, v33, v34
v_add3_u32 v1, v1, v35, s76
v_cmp_ne_u32 vcc, v1, v20
s_cbranch_vccnz LB0x
LB0g:
v_mfma_f32_16x16x32_bf16 v[184:187], v[32:35], v[72:75], v[184:187]
v_mfma_f32_16x16x32_bf16 v[188:191], v[32:35], v[76:79], v[188:191]
v_mfma_f32_16x16x32_bf16 v[176:179], v[32:35], v[64:67], v[176:179]
v_mfma_f32_16x16x32_bf16 v[180:183], v[32:35], v[68:71], v[180:183]
LB1:
s_waitcnt vmcnt(10)
v_add3_u32 v1, v36, v37, v38
v_add3_u32 v1, v1, v39, s76
v_cmp_ne_u32 vcc, v1, v21
s_cbranch_vccnz LB1x
LB1g:
v_mfma_f32_16x16x32_bf16 v[184:187], v[36:39], v[88:91], v[184:187]
v_mfma_f32_16x16x32_bf16 v[188:191], v[36:39], v[92:95], v[188:191]
v_mfma_f32_16x16x32_bf16 v[176:179], v[36:39], v[80:83], v[176:179]
v_mfma_f32_16x16x32_bf16 v[180:183], v[36:39], v[84:87], v[180:183]
LB2:
s_waitcnt vmcnt(8)
v_add3_u32 v1, v40, v41, v42
v_add3_u32 v1, v1, v43, s76
v_cmp_ne_u32 vcc, v1, v22
s_cbranch_vccnz LB2x
LB2g:
v_mfma_f32_16x16x32_bf16 v[184:187], v[40:43], v[104:107], v[184:187]
v_mfma_f32_16x16x32_bf16 v[188:191], v[40:43], v[108:111], v[188:191]
v_mfma_f32_16x16x32_bf16 v[176:179], v[40:43], v[96:99], v[176:179]
v_mfma_f32_16x16x32_bf16 v[180:183], v[40:43], v[100:103], v[180:183]
LB3:
s_waitcnt vmcnt(6)
v_add3_u32 v1, v44, v45, v46
v_add3_u32 v1, v1, v47, s76
v_cmp_ne_u32 vcc, v1, v23
s_cbranch_vccnz LB3x
LB3g:
v_mfma_f32_16x16x32_bf16 v[184:187], v[44:47], v[120:123], v[184:187]
v_mfma_f32_16x16x32_bf16 v[188:191], v[44:47], v[124:127], v[188:191]
v_mfma_f32_16x16x32_bf16 v[176:179], v[44:47], v[112:115], v[176:179]
v_mfma_f32_16x16x32_bf16 v[180:183], v[44:47], v[116:119], v[180:183]
LB4:
s_waitcnt vmcnt(4)
v_add3_u32 v1, v48, v49, v50
v_add3_u32 v1, v1, v51, s76
v_cmp_ne_u32 vcc, v1, v24
s_cbranch_vccnz LB4x
LB4g:
v_mfma_f32_16x16x32_bf16 v[184:187], v[48:51], v[136:139], v[184:187]
v_mfma_f32_16x16x32_bf16 v[188:191], v[48:51], v[140:143], v[188:191]
v_mfma_f32_16x16x32_bf16 v[176:179], v[48:51], v[128:131], v[176:179]
v_mfma_f32_16x16x32_bf16 v[180:183], v[48:51], v[132:135], v[180:183]
LB5:
s_waitcnt vmcnt(2)
v_add3_u32 v1, v52, v53, v54
v_add3_u32 v1, v1, v55, s76
v_cmp_ne_u32 vcc, v1, v25
s_cbranch_vccnz LB5x
LB5g:
v_mfma_f32_16x16x32_bf16 v[184:187], v[52:55], v[152:155], v[184:187]
v_mfma_f32_16x16x32_bf16 v[188:191], v[52:55], v[156:159], v[188:191]
v_mfma_f32_16x16x32_bf16 v[176:179], v[52:55], v[144:147], v[176:179]
v_mfma_f32_16x16x32_bf16 v[180:183], v[52:55], v[148:151], v[180:183]
LB6:
s_waitcnt vmcnt(0)
v_add3_u32 v1, v56, v57, v58
v_add3_u32 v1, v1, v59, s76
v_cmp_ne_u32 vcc, v1, v26
s_cbranch_vccnz LB6x
LB6g:
v_mfma_f32_16x16x32_bf16 v[184:187], v[56:59], v[168:171], v[184:187]
v_mfma_f32_16x16x32_bf16 v[188:191], v[56:59], v[172:175], v[188:191]
v_mfma_f32_16x16x32_bf16 v[176:179], v[56:59], v[160:163], v[176:179]
v_mfma_f32_16x16x32_bf16 v[180:183], v[56:59], v[164:167], v[180:183]
s_mov_b32 s66, 100000
s_nop 4
ds_write_b128 v17, v[184:187] offset:32768
ds_write_b128 v17, v[188:191] offset:33792
s_waitcnt lgkmcnt(0)
s_barrier
ds_read_b128 v[184:187], v18 offset:32768
ds_read_b128 v[188:191], v18 offset:33792
s_waitcnt lgkmcnt(1)
v_add_f32 v176, v176, v184
v_add_f32 v177, v177, v185
v_add_f32 v178, v178, v186
v_add_f32 v179, v179, v187
v_and_or_b32 v176, v176, s75, v60
v_and_or_b32 v177, v177, s75, v60
v_and_or_b32 v178, v178, s75, v60
v_and_or_b32 v179, v179, s75, v60
buffer_store_dwordx4 v[176:179], v16, s[32:35], s58 offen offset:0 sc1
s_waitcnt lgkmcnt(0)
v_add_f32 v180, v180, v188
v_add_f32 v181, v181, v189
v_add_f32 v182, v182, v190
v_add_f32 v183, v183, v191
v_and_or_b32 v180, v180, s75, v60
v_and_or_b32 v181, v181, s75, v60
v_and_or_b32 v182, v182, s75, v60
v_and_or_b32 v183, v183, s75, v60
buffer_store_dwordx4 v[180:183], v16, s[32:35], s58 offen offset:256 sc1
s_waitcnt vmcnt(0)
LpollC:
buffer_load_dwordx4 v[128:131], v27, s[32:35], s64 offen sc1
buffer_load_dwordx4 v[132:135], v27, s[32:35], s67 offen sc1
s_sub_u32 s66, s66, 1
s_cbranch_scc1 LdoneC
s_waitcnt vmcnt(1)
v_xor_b32 v128, v60, v128
v_xor_b32 v129, v60, v129
v_xor_b32 v130, v60, v130
v_xor_b32 v131, v60, v131
v_or_b32 v63, v128, v129
v_or3_b32 v63, v63, v130, v131
s_waitcnt vmcnt(0)
v_xor_b32 v132, v60, v132
v_xor_b32 v133, v60, v133
v_xor_b32 v134, v60, v134
v_xor_b32 v135, v60, v135
v_or3_b32 v63, v63, v132, v133
v_or3_b32 v63, v63, v134, v135
v_add_f32 v124, v128, v132
v_add_f32 v125, v129, v133
v_add_f32 v126, v130, v134
v_add_f32 v127, v131, v135
v_and_b32 v63, 0xff, v63
v_cmp_ne_u32 vcc, 0, v63
s_cbranch_vccnz LpollC
LdoneC:
v_permlane32_swap_b32 v124, v126
v_permlane32_swap_b32 v125, v127
s_nop 1
v_add_f32 v124, v124, v126
v_add_f32 v125, v125, v127
s_nop 1
v_permlane16_swap_b32 v124, v125
s_nop 1
v_add_f32 v124, v124, v125
v_cvt_pk_bf16_f32 v124, v124, v124
buffer_store_short v124, v28, s[36:39], s65 offen
s_mov_b32 s66, 100000
s_cmp_lg_u32 s47, 1
s_cbranch_scc1 Lend
s_cmp_lg_u32 s2, 0
s_cbranch_scc1 Lend
v_bfe_u32 v1, v0, 2, 3
v_lshlrev_b32 v1, 20, v1
v_and_b32 v3, 3, v0
v_lshl_add_u32 v1, v3, 7, v1
v_add_u32 v1, 536064, v1
s_lshl_b32 s50, s76, 4
LpollU:
buffer_load_dword v3, v1, s[32:35], 0 offen sc1
s_sub_u32 s66, s66, 1
s_cbranch_scc1 LdoneU
s_waitcnt vmcnt(0)
v_and_b32 v3, -16, v3
v_cmp_ne_u32 vcc, s50, v3
s_cbranch_vccnz LpollU
LdoneU:
s_mov_b64 exec, 1
v_mov_b32 v1, 12582912
v_mov_b32 v3, s76
buffer_store_dword v3, v1, s[32:35], 0 offen sc1
s_endpgm
Lnp:
s_add_u32 m0, s41, 0
s_add_u32 s50, s40, 0
buffer_load_dwordx4 v2, s[28:31], s50 offen lds
s_add_u32 m0, s41, 1024
s_add_u32 s50, s40, 65536
buffer_load_dwordx4 v3, s[28:31], s50 offen lds
s_add_u32 m0, s41, 2048
s_add_u32 s50, s40, 131072
buffer_load_dwordx4 v2, s[28:31], s50 offen lds
s_add_u32 m0, s41, 3072
s_add_u32 s50, s40, 196608
buffer_load_dwordx4 v3, s[28:31], s50 offen lds
s_add_u32 m0, s41, 4096
s_add_u32 s50, s40, 262144
buffer_load_dwordx4 v2, s[28:31], s50 offen lds
s_add_u32 m0, s41, 5120
s_add_u32 s50, s40, 327680
buffer_load_dwordx4 v3, s[28:31], s50 offen lds
s_add_u32 m0, s41, 6144
s_add_u32 s50, s40, 393216
buffer_load_dwordx4 v2, s[28:31], s50 offen lds
s_add_u32 m0, s41, 7168
s_add_u32 s50, s40, 458752
buffer_load_dwordx4 v3, s[28:31], s50 offen lds
s_waitcnt lgkmcnt(0)
s_barrier
s_branch Ljoin
LB0x:
s_sub_u32 s66, s66, 1
s_cbranch_scc1 LB0g
s_waitcnt vmcnt(0)
buffer_load_dwordx4 v[32:35], v12, s[32:35], s68 offen sc1
buffer_load_dword v20, v13, s[32:35], s60 offen offset:0 sc1
s_waitcnt vmcnt(0)
v_add3_u32 v1, v32, v33, v34
v_add3_u32 v1, v1, v35, s76
v_cmp_ne_u32 vcc, v1, v20
s_cbranch_vccnz LB0x
buffer_load_dwordx4 v[36:39], v12, s[32:35], s69 offen sc1
buffer_load_dword v21, v13, s[32:35], s60 offen offset:2048 sc1
buffer_load_dwordx4 v[40:43], v12, s[32:35], s70 offen sc1
buffer_load_dword v22, v13, s[32:35], s61 offen offset:0 sc1
buffer_load_dwordx4 v[44:47], v12, s[32:35], s71 offen sc1
buffer_load_dword v23, v13, s[32:35], s61 offen offset:2048 sc1
buffer_load_dwordx4 v[48:51], v12, s[32:35], s72 offen sc1
buffer_load_dword v24, v13, s[32:35], s62 offen offset:0 sc1
buffer_load_dwordx4 v[52:55], v12, s[32:35], s73 offen sc1
buffer_load_dword v25, v13, s[32:35], s62 offen offset:2048 sc1
buffer_load_dwordx4 v[56:59], v12, s[32:35], s74 offen sc1
buffer_load_dword v26, v13, s[32:35], s63 offen offset:0 sc1
s_branch LB0g
LB1x:
s_sub_u32 s66, s66, 1
s_cbranch_scc1 LB1g
s_waitcnt vmcnt(0)
buffer_load_dwordx4 v[36:39], v12, s[32:35], s69 offen sc1
buffer_load_dword v21, v13, s[32:35], s60 offen offset:2048 sc1
s_waitcnt vmcnt(0)
v_add3_u32 v1, v36, v37, v38
v_add3_u32 v1, v1, v39, s76
v_cmp_ne_u32 vcc, v1, v21
s_cbranch_vccnz LB1x
buffer_load_dwordx4 v[40:43], v12, s[32:35], s70 offen sc1
buffer_load_dword v22, v13, s[32:35], s61 offen offset:0 sc1
buffer_load_dwordx4 v[44:47], v12, s[32:35], s71 offen sc1
buffer_load_dword v23, v13, s[32:35], s61 offen offset:2048 sc1
buffer_load_dwordx4 v[48:51], v12, s[32:35], s72 offen sc1
buffer_load_dword v24, v13, s[32:35], s62 offen offset:0 sc1
buffer_load_dwordx4 v[52:55], v12, s[32:35], s73 offen sc1
buffer_load_dword v25, v13, s[32:35], s62 offen offset:2048 sc1
buffer_load_dwordx4 v[56:59], v12, s[32:35], s74 offen sc1
buffer_load_dword v26, v13, s[32:35], s63 offen offset:0 sc1
s_branch LB1g
LB2x:
s_sub_u32 s66, s66, 1
s_cbranch_scc1 LB2g
s_waitcnt vmcnt(0)
buffer_load_dwordx4 v[40:43], v12, s[32:35], s70 offen sc1
buffer_load_dword v22, v13, s[32:35], s61 offen offset:0 sc1
s_waitcnt vmcnt(0)
v_add3_u32 v1, v40, v41, v42
v_add3_u32 v1, v1, v43, s76
v_cmp_ne_u32 vcc, v1, v22
s_cbranch_vccnz LB2x
buffer_load_dwordx4 v[44:47], v12, s[32:35], s71 offen sc1
buffer_load_dword v23, v13, s[32:35], s61 offen offset:2048 sc1
buffer_load_dwordx4 v[48:51], v12, s[32:35], s72 offen sc1
buffer_load_dword v24, v13, s[32:35], s62 offen offset:0 sc1
buffer_load_dwordx4 v[52:55], v12, s[32:35], s73 offen sc1
buffer_load_dword v25, v13, s[32:35], s62 offen offset:2048 sc1
buffer_load_dwordx4 v[56:59], v12, s[32:35], s74 offen sc1
buffer_load_dword v26, v13, s[32:35], s63 offen offset:0 sc1
s_branch LB2g
LB3x:
s_sub_u32 s66, s66, 1
s_cbranch_scc1 LB3g
s_waitcnt vmcnt(0)
buffer_load_dwordx4 v[44:47], v12, s[32:35], s71 offen sc1
buffer_load_dword v23, v13, s[32:35], s61 offen offset:2048 sc1
s_waitcnt vmcnt(0)
v_add3_u32 v1, v44, v45, v46
v_add3_u32 v1, v1, v47, s76
v_cmp_ne_u32 vcc, v1, v23
s_cbranch_vccnz LB3x
buffer_load_dwordx4 v[48:51], v12, s[32:35], s72 offen sc1
buffer_load_dword v24, v13, s[32:35], s62 offen offset:0 sc1
buffer_load_dwordx4 v[52:55], v12, s[32:35], s73 offen sc1
buffer_load_dword v25, v13, s[32:35], s62 offen offset:2048 sc1
buffer_load_dwordx4 v[56:59], v12, s[32:35], s74 offen sc1
buffer_load_dword v26, v13, s[32:35], s63 offen offset:0 sc1
s_branch LB3g
LB4x:
s_sub_u32 s66, s66, 1
s_cbranch_scc1 LB4g
s_waitcnt vmcnt(0)
buffer_load_dwordx4 v[48:51], v12, s[32:35], s72 offen sc1
buffer_load_dword v24, v13, s[32:35], s62 offen offset:0 sc1
s_waitcnt vmcnt(0)
v_add3_u32 v1, v48, v49, v50
v_add3_u32 v1, v1, v51, s76
v_cmp_ne_u32 vcc, v1, v24
s_cbranch_vccnz LB4x
buffer_load_dwordx4 v[52:55], v12, s[32:35], s73 offen sc1
buffer_load_dword v25, v13, s[32:35], s62 offen offset:2048 sc1
buffer_load_dwordx4 v[56:59], v12, s[32:35], s74 offen sc1
buffer_load_dword v26, v13, s[32:35], s63 offen offset:0 sc1
s_branch LB4g
LB5x:
s_sub_u32 s66, s66, 1
s_cbranch_scc1 LB5g
s_waitcnt vmcnt(0)
buffer_load_dwordx4 v[52:55], v12, s[32:35], s73 offen sc1
buffer_load_dword v25, v13, s[32:35], s62 offen offset:2048 sc1
s_waitcnt vmcnt(0)
v_add3_u32 v1, v52, v53, v54
v_add3_u32 v1, v1, v55, s76
v_cmp_ne_u32 vcc, v1, v25
s_cbranch_vccnz LB5x
buffer_load_dwordx4 v[56:59], v12, s[32:35], s74 offen sc1
buffer_load_dword v26, v13, s[32:35], s63 offen offset:0 sc1
s_branch LB5g
LB6x:
s_sub_u32 s66, s66, 1
s_cbranch_scc1 LB6g
s_waitcnt vmcnt(0)
buffer_load_dwordx4 v[56:59], v12, s[32:35], s74 offen sc1
buffer_load_dword v26, v13, s[32:35], s63 offen offset:0 sc1
s_waitcnt vmcnt(0)
v_add3_u32 v1, v56, v57, v58
v_add3_u32 v1, v1, v59, s76
v_cmp_ne_u32 vcc, v1, v26
s_cbranch_vccnz LB6x
s_branch LB6g
LP1:
s_getreg_b32 s78, hwreg(HW_REG_XCC_ID, 0, 4)
s_waitcnt lgkmcnt(0)
s_add_u32 s18, s16, 12582912
s_addc_u32 s19, s17, 0
s_load_dword s76, s[18:19], 0
s_mov_b32 s32, s16
s_and_b32 s33, s17, 0xffff
s_mov_b32 s34, 268435456
s_mov_b32 s35, 0x20000

s_cmp_lt_u32 s45, 28
s_cbranch_scc1 LP1p
s_mov_b32 s20, s4
s_and_b32 s21, s5, 0xffff
s_mov_b32 s22, 131072
s_mov_b32 s23, 0x20000

v_lshlrev_b32 v12, 4, v0
s_sub_u32 s50, s45, 28
s_lshl_b32 s50, s50, 2
s_add_u32 s50, s50, s3
s_lshl_b32 s50, s50, 10
s_add_u32 s52, s50, 0
buffer_load_dwordx4 v[16:19], v12, s[20:23], s52 offen
s_add_u32 s52, s50, 16384
buffer_load_dwordx4 v[16:19], v12, s[20:23], s52 offen
s_add_u32 s52, s50, 32768
buffer_load_dwordx4 v[16:19], v12, s[20:23], s52 offen
s_add_u32 s52, s50, 49152
buffer_load_dwordx4 v[16:19], v12, s[20:23], s52 offen
s_add_u32 s52, s50, 65536
buffer_load_dwordx4 v[16:19], v12, s[20:23], s52 offen
s_add_u32 s52, s50, 81920
buffer_load_dwordx4 v[16:19], v12, s[20:23], s52 offen
s_add_u32 s52, s50, 98304
buffer_load_dwordx4 v[16:19], v12, s[20:23], s52 offen
s_add_u32 s52, s50, 114688
buffer_load_dwordx4 v[16:19], v12, s[20:23], s52 offen
s_waitcnt lgkmcnt(0)
s_barrier
s_add_u32 s76, s76, 1
s_and_b32 s77, s76, 0xff
v_mov_b32 v60, s77
s_mov_b32 s75, 0xffffff00
s_lshl_b32 s79, s76, 4
s_or_b32 s79, s79, s78
s_cmp_lg_u32 s3, 0
s_cbranch_scc1 Lxp0
s_lshl_b32 s50, s45, 7
s_add_u32 s50, s50, s46
s_add_u32 s50, s50, 532480
s_mov_b64 exec, 1
v_mov_b32 v1, 0
v_mov_b32 v3, s79
buffer_store_dword v3, v1, s[32:35], s50 offen sc1
s_mov_b64 exec, -1
Lxp0:
s_endpgm
LP1p:
s_lshr_b32 s59, s45, 2
s_and_b32 s48, s45, 3
s_and_b32 s56, s3, 1
s_lshr_b32 s57, s3, 1
s_lshl_b32 s54, s3, 10
v_lshrrev_b32 v1, 5, v0
v_bfe_u32 v3, v0, 2, 2
v_lshl_add_u32 v1, v1, 3, v3
v_lshlrev_b32 v6, 7, v1
v_bfe_u32 v1, v0, 4, 1
v_bfe_u32 v3, v0, 1, 1
v_lshl_add_u32 v1, v1, 1, v3
v_xor_b32 v1, s48, v1
v_bfe_u32 v3, v0, 3, 1
v_xor_b32 v3, s57, v3
v_lshl_add_u32 v1, v3, 2, v1
v_lshl_add_u32 v6, v1, 4, v6
v_and_b32 v3, 1, v0
v_lshl_add_u32 v6, v3, 3, v6
v_and_b32 v1, 31, v0
s_lshl_b32 s50, s56, 5
v_add_u32 v1, s50, v1
v_lshlrev_b32 v1, 7, v1
v_add_u32 v1, 8192, v1
v_bfe_u32 v3, v0, 1, 3
v_lshrrev_b32 v4, 5, v0
v_add_u32 v7, 0, v4
v_xor_b32 v7, v7, v3
v_lshl_add_u32 v8, v7, 4, v1
v_add_u32 v7, 2, v4
v_xor_b32 v7, v7, v3
v_lshl_add_u32 v9, v7, 4, v1
v_add_u32 v7, 4, v4
v_xor_b32 v7, v7, v3
v_lshl_add_u32 v10, v7, 4, v1
v_add_u32 v7, 6, v4
v_xor_b32 v7, v7, v3
v_lshl_add_u32 v11, v7, 4, v1
v_mov_b32 v16, 0
v_mov_b32 v17, 0
v_mov_b32 v18, 0
v_mov_b32 v19, 0
v_mov_b32 v20, 0
v_mov_b32 v21, 0
v_mov_b32 v22, 0
v_mov_b32 v23, 0
v_mov_b32 v24, 0
v_mov_b32 v25, 0
v_mov_b32 v26, 0
v_mov_b32 v27, 0
v_mov_b32 v28, 0
v_mov_b32 v29, 0
v_mov_b32 v30, 0
v_mov_b32 v31, 0
v_lshlrev_b32 v12, 4, v0
s_add_u32 s51, s54, s46
s_lshl_b32 s50, s45, 14
s_add_u32 s50, s50, s51
s_add_u32 s61, s50, 4096
s_xor_b32 s50, s45, 1
s_lshl_b32 s50, s50, 14
s_add_u32 s50, s50, s51
s_add_u32 s64, s50, 4096
s_lshl_b32 s50, s45, 14
s_add_u32 s50, s50, s51
s_add_u32 s62, s50, 8192
s_xor_b32 s50, s45, 2
s_lshl_b32 s50, s50, 14
s_add_u32 s50, s50, s51
s_add_u32 s65, s50, 8192
s_lshl_b32 s50, s45, 14
s_add_u32 s50, s50, s51
s_add_u32 s63, s50, 12288
s_xor_b32 s50, s45, 3
s_lshl_b32 s50, s50, 14
s_add_u32 s50, s50, s51
s_add_u32 s66, s50, 12288
s_lshr_b32 s50, s45, 1
s_lshl_b32 s50, s50, 1
s_add_u32 s50, s50, s56
s_lshl_b32 s50, s50, 2
s_and_b32 s51, s48, 1
s_add_u32 s50, s50, s51
s_lshl_b32 s50, s50, 1
s_add_u32 s50, s50, s57
s_lshl_b32 s68, s50, 8
s_lshl_b32 s69, s50, 6
s_add_u32 s68, s68, s46
s_add_u32 s68, s68, 458752
s_add_u32 s69, s69, s46
s_add_u32 s69, s69, 516096
v_bfe_u32 v1, v0, 4, 1
v_and_b32 v3, 15, v0
v_lshl_add_u32 v1, v1, 6, v3
v_lshlrev_b32 v14, 2, v1
v_lshlrev_b32 v13, 4, v1
v_lshrrev_b32 v3, 5, v0
v_lshl_add_u32 v13, v3, 3, v13
v_and_b32 v15, 31, v0
v_lshlrev_b32 v15, 7, v15
s_add_u32 s70, s46, 532480
s_waitcnt lgkmcnt(0)
s_add_u32 s76, s76, 1
s_and_b32 s77, s76, 0xff
v_mov_b32 v60, s77
s_mov_b32 s75, 0xffffff00
s_lshl_b32 s79, s76, 4
s_or_b32 s79, s79, s78
s_cmp_lg_u32 s3, 0
s_cbranch_scc1 Lxp1
s_lshl_b32 s50, s45, 7
s_add_u32 s50, s50, s46
s_add_u32 s50, s50, 532480
s_mov_b64 exec, 1
v_mov_b32 v1, 0
v_mov_b32 v3, s79
buffer_store_dword v3, v1, s[32:35], s50 offen sc1
s_mov_b64 exec, -1
Lxp1:
s_barrier
ds_read_b64_tr_b16 v[64:65], v6 offset:0
ds_read_b64_tr_b16 v[66:67], v6 offset:512
ds_read_b128 v[68:71], v8 offset:0
ds_read_b64_tr_b16 v[72:73], v6 offset:2048
ds_read_b64_tr_b16 v[74:75], v6 offset:2560
ds_read_b128 v[76:79], v9 offset:0
ds_read_b64_tr_b16 v[80:81], v6 offset:4096
ds_read_b64_tr_b16 v[82:83], v6 offset:4608
ds_read_b128 v[84:87], v10 offset:0
ds_read_b64_tr_b16 v[88:89], v6 offset:6144
ds_read_b64_tr_b16 v[90:91], v6 offset:6656
ds_read_b128 v[92:95], v11 offset:0
s_waitcnt lgkmcnt(9)
v_mfma_f32_32x32x16_bf16 v[16:31], v[64:67], v[68:71], v[16:31]
s_barrier
ds_read_b64_tr_b16 v[96:97], v6 offset:16384
ds_read_b64_tr_b16 v[98:99], v6 offset:16896
ds_read_b128 v[100:103], v8 offset:16384
s_waitcnt lgkmcnt(9)
v_mfma_f32_32x32x16_bf16 v[16:31], v[72:75], v[76:79], v[16:31]
ds_read_b64_tr_b16 v[64:65], v6 offset:18432
ds_read_b64_tr_b16 v[66:67], v6 offset:18944
ds_read_b128 v[68:71], v9 offset:16384
s_waitcnt lgkmcnt(9)
v_mfma_f32_32x32x16_bf16 v[16:31], v[80:83], v[84:87], v[16:31]
ds_read_b64_tr_b16 v[72:73], v6 offset:20480
ds_read_b64_tr_b16 v[74:75], v6 offset:20992
ds_read_b128 v[76:79], v10 offset:16384
s_waitcnt lgkmcnt(9)
v_mfma_f32_32x32x16_bf16 v[16:31], v[88:91], v[92:95], v[16:31]
ds_read_b64_tr_b16 v[80:81], v6 offset:22528
ds_read_b64_tr_b16 v[82:83], v6 offset:23040
ds_read_b128 v[84:87], v11 offset:16384
s_waitcnt lgkmcnt(9)
v_mfma_f32_32x32x16_bf16 v[16:31], v[96:99], v[100:103], v[16:31]
s_barrier
buffer_load_dword v61, v15, s[32:35], s70 offen sc1
ds_read_b64_tr_b16 v[88:89], v6 offset:32768
ds_read_b64_tr_b16 v[90:91], v6 offset:33280
ds_read_b128 v[92:95], v8 offset:32768
s_waitcnt lgkmcnt(9)
v_mfma_f32_32x32x16_bf16 v[16:31], v[64:67], v[68:71], v[16:31]
ds_read_b64_tr_b16 v[96:97], v6 offset:34816
ds_read_b64_tr_b16 v[98:99], v6 offset:35328
ds_read_b128 v[100:103], v9 offset:32768
s_waitcnt lgkmcnt(9)
v_mfma_f32_32x32x16_bf16 v[16:31], v[72:75], v[76:79], v[16:31]
ds_read_b64_tr_b16 v[64:65], v6 offset:36864
ds_read_b64_tr_b16 v[66:67], v6 offset:37376
ds_read_b128 v[68:71], v10 offset:32768
s_waitcnt lgkmcnt(9)
v_mfma_f32_32x32x16_bf16 v[16:31], v[80:83], v[84:87], v[16:31]
ds_read_b64_tr_b16 v[72:73], v6 offset:38912
ds_read_b64_tr_b16 v[74:75], v6 offset:39424
ds_read_b128 v[76:79], v11 offset:32768
s_waitcnt lgkmcnt(9)
v_mfma_f32_32x32x16_bf16 v[16:31], v[88:91], v[92:95], v[16:31]
s_barrier
ds_read_b64_tr_b16 v[80:81], v6 offset:49152
ds_read_b64_tr_b16 v[82:83], v6 offset:49664
ds_read_b128 v[84:87], v8 offset:49152
s_waitcnt lgkmcnt(9)
v_mfma_f32_32x32x16_bf16 v[16:31], v[96:99], v[100:103], v[16:31]
ds_read_b64_tr_b16 v[88:89], v6 offset:51200
ds_read_b64_tr_b16 v[90:91], v6 offset:51712
ds_read_b128 v[92:95], v9 offset:49152
s_waitcnt lgkmcnt(9)
v_mfma_f32_32x32x16_bf16 v[16:31], v[64:67], v[68:71], v[16:31]
ds_read_b64_tr_b16 v[96:97], v6 offset:53248
ds_read_b64_tr_b16 v[98:99], v6 offset:53760
ds_read_b128 v[100:103], v10 offset:49152
s_waitcnt lgkmcnt(9)
v_mfma_f32_32x32x16_bf16 v[16:31], v[72:75], v[76:79], v[16:31]
ds_read_b64_tr_b16 v[64:65], v6 offset:55296
ds_read_b64_tr_b16 v[66:67], v6 offset:55808
ds_read_b128 v[68:71], v11 offset:49152
s_waitcnt lgkmcnt(9)
v_mfma_f32_32x32x16_bf16 v[16:31], v[80:83], v[84:87], v[16:31]
s_barrier
v_add_u32 v6, 0x10000, v6
v_add_u32 v8, 0x10000, v8
v_add_u32 v9, 0x10000, v9
v_add_u32 v10, 0x10000, v10
v_add_u32 v11, 0x10000, v11
ds_read_b64_tr_b16 v[72:73], v6 offset:0
ds_read_b64_tr_b16 v[74:75], v6 offset:512
ds_read_b128 v[76:79], v8 offset:0
s_waitcnt lgkmcnt(9)
v_mfma_f32_32x32x16_bf16 v[16:31], v[88:91], v[92:95], v[16:31]
ds_read_b64_tr_b16 v[80:81], v6 offset:2048
ds_read_b64_tr_b16 v[82:83], v6 offset:2560
ds_read_b128 v[84:87], v9 offset:0
s_waitcnt lgkmcnt(9)
v_mfma_f32_32x32x16_bf16 v[16:31], v[96:99], v[100:103], v[16:31]
ds_read_b64_tr_b16 v[88:89], v6 offset:4096
ds_read_b64_tr_b16 v[90:91], v6 offset:4608
ds_read_b128 v[92:95], v10 offset:0
s_waitcnt lgkmcnt(9)
v_mfma_f32_32x32x16_bf16 v[16:31], v[64:67], v[68:71], v[16:31]
ds_read_b64_tr_b16 v[96:97], v6 offset:6144
ds_read_b64_tr_b16 v[98:99], v6 offset:6656
ds_read_b128 v[100:103], v11 offset:0
s_waitcnt lgkmcnt(9)
v_mfma_f32_32x32x16_bf16 v[16:31], v[72:75], v[76:79], v[16:31]
s_barrier
ds_read_b64_tr_b16 v[64:65], v6 offset:16384
ds_read_b64_tr_b16 v[66:67], v6 offset:16896
ds_read_b128 v[68:71], v8 offset:16384
s_waitcnt lgkmcnt(9)
v_mfma_f32_32x32x16_bf16 v[16:31], v[80:83], v[84:87], v[16:31]
ds_read_b64_tr_b16 v[72:73], v6 offset:18432
ds_read_b64_tr_b16 v[74:75], v6 offset:18944
ds_read_b128 v[76:79], v9 offset:16384
s_waitcnt lgkmcnt(9)
v_mfma_f32_32x32x16_bf16 v[16:31], v[88:91], v[92:95], v[16:31]
ds_read_b64_tr_b16 v[80:81], v6 offset:20480
ds_read_b64_tr_b16 v[82:83], v6 offset:20992
ds_read_b128 v[84:87], v10 offset:16384
s_waitcnt lgkmcnt(9)
v_mfma_f32_32x32x16_bf16 v[16:31], v[96:99], v[100:103], v[16:31]
ds_read_b64_tr_b16 v[88:89], v6 offset:22528
ds_read_b64_tr_b16 v[90:91], v6 offset:23040
ds_read_b128 v[92:95], v11 offset:16384
s_waitcnt lgkmcnt(9)
v_mfma_f32_32x32x16_bf16 v[16:31], v[64:67], v[68:71], v[16:31]
s_barrier
ds_read_b64_tr_b16 v[96:97], v6 offset:32768
ds_read_b64_tr_b16 v[98:99], v6 offset:33280
ds_read_b128 v[100:103], v8 offset:32768
s_waitcnt lgkmcnt(9)
v_mfma_f32_32x32x16_bf16 v[16:31], v[72:75], v[76:79], v[16:31]
ds_read_b64_tr_b16 v[64:65], v6 offset:34816
ds_read_b64_tr_b16 v[66:67], v6 offset:35328
ds_read_b128 v[68:71], v9 offset:32768
s_waitcnt lgkmcnt(9)
v_mfma_f32_32x32x16_bf16 v[16:31], v[80:83], v[84:87], v[16:31]
ds_read_b64_tr_b16 v[72:73], v6 offset:36864
ds_read_b64_tr_b16 v[74:75], v6 offset:37376
ds_read_b128 v[76:79], v10 offset:32768
s_waitcnt lgkmcnt(9)
v_mfma_f32_32x32x16_bf16 v[16:31], v[88:91], v[92:95], v[16:31]
ds_read_b64_tr_b16 v[80:81], v6 offset:38912
ds_read_b64_tr_b16 v[82:83], v6 offset:39424
ds_read_b128 v[84:87], v11 offset:32768
s_waitcnt lgkmcnt(9)
v_mfma_f32_32x32x16_bf16 v[16:31], v[96:99], v[100:103], v[16:31]
s_barrier
ds_read_b64_tr_b16 v[88:89], v6 offset:49152
ds_read_b64_tr_b16 v[90:91], v6 offset:49664
ds_read_b128 v[92:95], v8 offset:49152
s_waitcnt lgkmcnt(9)
v_mfma_f32_32x32x16_bf16 v[16:31], v[64:67], v[68:71], v[16:31]
ds_read_b64_tr_b16 v[96:97], v6 offset:51200
ds_read_b64_tr_b16 v[98:99], v6 offset:51712
ds_read_b128 v[100:103], v9 offset:49152
s_waitcnt lgkmcnt(9)
v_mfma_f32_32x32x16_bf16 v[16:31], v[72:75], v[76:79], v[16:31]
ds_read_b64_tr_b16 v[64:65], v6 offset:53248
ds_read_b64_tr_b16 v[66:67], v6 offset:53760
ds_read_b128 v[68:71], v10 offset:49152
s_waitcnt lgkmcnt(9)
v_mfma_f32_32x32x16_bf16 v[16:31], v[80:83], v[84:87], v[16:31]
ds_read_b64_tr_b16 v[72:73], v6 offset:55296
ds_read_b64_tr_b16 v[74:75], v6 offset:55808
ds_read_b128 v[76:79], v11 offset:49152
s_waitcnt lgkmcnt(9)
v_mfma_f32_32x32x16_bf16 v[16:31], v[88:91], v[92:95], v[16:31]
s_waitcnt lgkmcnt(6)
v_mfma_f32_32x32x16_bf16 v[16:31], v[96:99], v[100:103], v[16:31]
s_waitcnt lgkmcnt(3)
v_mfma_f32_32x32x16_bf16 v[16:31], v[64:67], v[68:71], v[16:31]
s_waitcnt lgkmcnt(0)
v_mfma_f32_32x32x16_bf16 v[16:31], v[72:75], v[76:79], v[16:31]
s_mov_b32 s67, 100000
s_waitcnt vmcnt(0)
v_cmp_ne_u32 s[72:73], s79, v61
s_nop 7
s_cmp_eq_u64 s[72:73], 0
s_cbranch_scc1 Lxok
buffer_load_dword v190, v15, s[32:35], s70 offen sc1
s_waitcnt vmcnt(0)
v_cmp_ne_u32 s[72:73], s79, v190
s_nop 4
Lxok:
s_cmp_lg_u64 s[72:73], 0
s_cbranch_scc1 LslowA
v_and_or_b32 v20, v20, s75, v60
v_and_or_b32 v21, v21, s75, v60
v_and_or_b32 v22, v22, s75, v60
v_and_or_b32 v23, v23, s75, v60
buffer_store_dwordx4 v[20:23], v12, s[32:35], s61 offen
v_and_or_b32 v24, v24, s75, v60
v_and_or_b32 v25, v25, s75, v60
v_and_or_b32 v26, v26, s75, v60
v_and_or_b32 v27, v27, s75, v60
buffer_store_dwordx4 v[24:27], v12, s[32:35], s62 offen
v_and_or_b32 v28, v28, s75, v60
v_and_or_b32 v29, v29, s75, v60
v_and_or_b32 v30, v30, s75, v60
v_and_or_b32 v31, v31, s75, v60
buffer_store_dwordx4 v[28:31], v12, s[32:35], s63 offen
LpollA:
buffer_load_dwordx4 v[36:39], v12, s[32:35], s64 offen sc1
buffer_load_dwordx4 v[40:43], v12, s[32:35], s65 offen sc1
buffer_load_dwordx4 v[44:47], v12, s[32:35], s66 offen sc1
s_sub_u32 s67, s67, 1
s_cbranch_scc1 LdoneA
s_waitcnt vmcnt(2)
v_xor_b32 v36, v60, v36
v_xor_b32 v37, v60, v37
v_xor_b32 v38, v60, v38
v_xor_b32 v39, v60, v39
v_or_b32 v63, v36, v37
v_or3_b32 v63, v63, v38, v39
s_waitcnt vmcnt(1)
v_xor_b32 v40, v60, v40
v_xor_b32 v41, v60, v41
v_xor_b32 v42, v60, v42
v_xor_b32 v43, v60, v43
v_or3_b32 v63, v63, v40, v41
v_or3_b32 v63, v63, v42, v43
s_waitcnt vmcnt(0)
v_xor_b32 v44, v60, v44
v_xor_b32 v45, v60, v45
v_xor_b32 v46, v60, v46
v_xor_b32 v47, v60, v47
v_or3_b32 v63, v63, v44, v45
v_or3_b32 v63, v63, v46, v47
v_and_b32 v63, 0xff, v63
v_cmp_ne_u32 vcc, 0, v63
s_cbranch_vccnz LpollA
LdoneA:
s_barrier
s_cmp_lt_u32 s48, 2
s_cbranch_scc1 Lgu0
v_add_f32 v32, v40, v44
v_add_f32 v40, v16, v36
v_add_f32 v33, v41, v45
v_add_f32 v41, v17, v37
v_add_f32 v34, v42, v46
v_add_f32 v42, v18, v38
v_add_f32 v35, v43, v47
v_add_f32 v43, v19, v39
s_branch Lgu1
Lgu0:
v_add_f32 v32, v16, v36
v_add_f32 v40, v40, v44
v_add_f32 v33, v17, v37
v_add_f32 v41, v41, v45
v_add_f32 v34, v18, v38
v_add_f32 v42, v42, v46
v_add_f32 v35, v19, v39
v_add_f32 v43, v43, v47
Lgu1:
v_cvt_pk_bf16_f32 v48, v32, v33
v_cvt_pk_bf16_f32 v49, v34, v35
v_lshlrev_b32 v32, 16, v48
v_and_b32 v33, 0xffff0000, v48
v_lshlrev_b32 v34, 16, v49
v_and_b32 v35, 0xffff0000, v49
v_mul_f32 v36, 0xbfb8aa3b, v32
v_mul_f32 v37, 0xbfb8aa3b, v33
v_mul_f32 v38, 0xbfb8aa3b, v34
v_mul_f32 v39, 0xbfb8aa3b, v35
v_exp_f32 v36, v36
v_exp_f32 v37, v37
v_exp_f32 v38, v38
v_exp_f32 v39, v39
v_cvt_pk_bf16_f32 v48, v40, v41
v_cvt_pk_bf16_f32 v49, v42, v43
v_lshlrev_b32 v40, 16, v48
v_and_b32 v41, 0xffff0000, v48
v_lshlrev_b32 v42, 16, v49
v_and_b32 v43, 0xffff0000, v49
v_add_f32 v36, 1.0, v36
v_add_f32 v37, 1.0, v37
v_add_f32 v38, 1.0, v38
v_add_f32 v39, 1.0, v39
v_rcp_f32 v36, v36
v_rcp_f32 v37, v37
v_rcp_f32 v38, v38
v_rcp_f32 v39, v39
v_mul_f32 v32, v32, v36
v_mul_f32 v33, v33, v37
v_mul_f32 v34, v34, v38
v_mul_f32 v35, v35, v39
v_cvt_pk_bf16_f32 v48, v32, v33
v_cvt_pk_bf16_f32 v49, v34, v35
v_lshlrev_b32 v32, 16, v48
v_and_b32 v33, 0xffff0000, v48
v_lshlrev_b32 v34, 16, v49
v_and_b32 v35, 0xffff0000, v49
v_mul_f32 v32, v32, v40
v_mul_f32 v33, v33, v41
v_mul_f32 v34, v34, v42
v_mul_f32 v35, v35, v43
v_cvt_pk_bf16_f32 v48, v32, v33
v_cvt_pk_bf16_f32 v49, v34, v35
s_cmp_lg_u64 s[72:73], 0
v_add_u32 v50, v48, v49
v_add_u32 v51, v48, v49
s_cbranch_scc1 LslowB
buffer_store_dwordx2 v[48:49], v13, s[32:35], s68 offen
v_permlane32_swap_b32 v50, v51
s_nop 1
v_add3_u32 v50, v50, v51, s76
s_mov_b32 exec_hi, 0
buffer_store_dword v50, v14, s[32:35], s69 offen
s_mov_b32 exec_hi, -1
LdoneB:
s_barrier
s_endpgm
LslowA:
v_and_or_b32 v20, v20, s75, v60
v_and_or_b32 v21, v21, s75, v60
v_and_or_b32 v22, v22, s75, v60
v_and_or_b32 v23, v23, s75, v60
buffer_store_dwordx4 v[20:23], v12, s[32:35], s61 offen sc1
v_and_or_b32 v24, v24, s75, v60
v_and_or_b32 v25, v25, s75, v60
v_and_or_b32 v26, v26, s75, v60
v_and_or_b32 v27, v27, s75, v60
buffer_store_dwordx4 v[24:27], v12, s[32:35], s62 offen sc1
v_and_or_b32 v28, v28, s75, v60
v_and_or_b32 v29, v29, s75, v60
v_and_or_b32 v30, v30, s75, v60
v_and_or_b32 v31, v31, s75, v60
buffer_store_dwordx4 v[28:31], v12, s[32:35], s63 offen sc1
s_branch LpollA
LslowB:
buffer_store_dwordx2 v[48:49], v13, s[32:35], s68 offen sc1
v_permlane32_swap_b32 v50, v51
s_nop 1
v_add3_u32 v50, v50, v51, s76
s_mov_b32 exec_hi, 0
buffer_store_dword v50, v14, s[32:35], s69 offen sc1
s_mov_b32 exec_hi, -1
s_branch LdoneB
Lend:
s_endpgm
.section .rodata,"a"
.p2align 6
.amdhsa_kernel standalone__glu_gated_swiglu__sampling_kernel
  .amdhsa_next_free_vgpr 192
  .amdhsa_next_free_sgpr 102
  .amdhsa_accum_offset 192
  .amdhsa_group_segment_fixed_size 0
  .amdhsa_kernarg_size 56
  .amdhsa_user_sgpr_count 2
  .amdhsa_user_sgpr_kernarg_segment_ptr 1
  .amdhsa_system_sgpr_workgroup_id_x 1
.end_amdhsa_kernel
```
